```python
import torch

def _softmax(x, axis=-1):
    return torch.softmax(x, dim=axis)
def _gelu(x):
    return torch.nn.functional.gelu(x, approximate="tanh")
def _silu(x):
    return torch.nn.functional.silu(x)
def _sigmoid(x):
    return torch.sigmoid(x)
def _layernorm(x, axis=-1, eps=1e-5):
    m = x.mean(dim=axis, keepdim=True)
    v = x.var(dim=axis, keepdim=True, unbiased=False)
    return (x - m) / torch.sqrt(v + eps)
def _scatter_add(tgt, idx, src, axis=0):
    return tgt.clone().index_add_(axis, idx, src)
def _segment_sum(src, seg, n):
    out = torch.zeros((n,) + src.shape[1:], dtype=src.dtype)
    return out.index_add_(0, seg, src)
def _pad(x, pw):
    flat = tuple(v for pair in reversed(pw) for v in pair)
    return torch.nn.functional.pad(x, flat)

kernel_name = 'gated_mix__sliding_block_cached__glu_gated_swiglu__decode'

def setup_inputs():

    _w = (lambda a: (lambda t: t.to(torch.bfloat16) if t.is_floating_point() else t)(torch.as_tensor(a)))
    def _A_setup():
        B, Sq, D = 8, 1, 512
        Hq, Hkv, Sk, Dh = 32, 8, 4096, 128
        assert Hq % Hkv == 0, (Hq, Hkv)
        return {
            "x": _w((lambda *s: torch.randn(*s, dtype=torch.bfloat16) * 0.05)(B, Sq, D)),
            "k_cache": _w((lambda *s: torch.randn(*s, dtype=torch.bfloat16) * 3.2)(B, Hkv, Sk, Dh)),
            "v_cache": _w((lambda *s: torch.randn(*s, dtype=torch.bfloat16) * 0.05)(B, Hkv, Sk, Dh)),
            "wq": _w((lambda *s: torch.randn(*s, dtype=torch.bfloat16) * 3.2)(D, Hq * Dh) * (D ** -0.5)),
            "wo": _w((lambda *s: torch.randn(*s, dtype=torch.bfloat16) * 0.05)(Hq * Dh, D) * ((Hq * Dh) ** -0.5)),
        }
    _A_in = _A_setup()

    def _B_setup():
        B, S, D, F = 8, 1, 512, 1792
        return {
            "x": _w((lambda *s: torch.randn(*s, dtype=torch.bfloat16) * 0.05)(B, S, D)),
            "w1": _w((lambda *s: torch.randn(*s, dtype=torch.bfloat16) * 0.2)(D, F) * (2.0 / D) ** 0.5),
            "w3": _w((lambda *s: torch.randn(*s, dtype=torch.bfloat16) * 0.2)(D, F) * (2.0 / D) ** 0.5),
            "w2": _w((lambda *s: torch.randn(*s, dtype=torch.bfloat16) * 0.2)(F, D) * (2.0 / F) ** 0.5),
        }
    _B_in = _B_setup()

    return {
        "A_x": _A_in["x"],
        "A_k_cache": _A_in["k_cache"],
        "A_v_cache": _A_in["v_cache"],
        "A_wq": _A_in["wq"],
        "A_wo": _A_in["wo"],
        "B_x": _B_in["x"],
        "B_w1": _B_in["w1"],
        "B_w3": _B_in["w3"],
        "B_w2": _B_in["w2"],
        "gate_w": _w((lambda *s: torch.randn(*s, dtype=torch.bfloat16) * 0.05)(512) * 16.0),
    }

def reference(A_x, A_k_cache, A_v_cache, A_wq, A_wo, B_x, B_w1, B_w3, B_w2, gate_w):
    def _A_ref(x, k_cache, v_cache, wq, wo):
        B, Sq, D = x.shape
        Hq, Dh = 32, 128
        Hkv, Sk = k_cache.shape[1], k_cache.shape[2]
        W = min(4096, max(256, Sk // 4))
        rep = Hq // Hkv
        q = (lambda x, *d: x.permute(*d))((x @ wq).reshape(B, Sq, Hq, Dh), 0, 2, 1, 3)
        k = (lambda x, n, axis: torch.repeat_interleave(x, n, dim=axis))(k_cache[:, :, Sk - W:, :], rep, axis=1)
        v = (lambda x, n, axis: torch.repeat_interleave(x, n, dim=axis))(v_cache[:, :, Sk - W:, :], rep, axis=1)
        scores = torch.einsum("bhqd,bhkd->bhqk", q, k) * (Dh ** -0.5)
        p = _softmax(scores, axis=-1)
        o = torch.einsum("bhqk,bhkd->bhqd", p, v)
        return (lambda x, *d: x.permute(*d))(o, 0, 2, 1, 3).reshape(B, Sq, Hq * Dh) @ wo

    def _B_ref(x, w1, w3, w2):
        gate = torch.einsum("bsd,df->bsf", x, w1)
        up = torch.einsum("bsd,df->bsf", x, w3)
        h = _silu(gate) * up
        out = torch.einsum("bsf,fd->bsd", h, w2)
        return out

    x = A_x
    g = _sigmoid((x * gate_w).sum(-1, keepdims=True))
    a = _A_ref(x, A_k_cache, A_v_cache, A_wq, A_wo)
    b = _B_ref(x, B_w1, B_w3, B_w2)
    return g * a + (1 - g) * b
```

```asm
; @launch grid=(256,1,1) block=(320,1,1) lds=163840
.amdgcn_target "amdgcn-amd-amdhsa--gfx950"
.text
.globl gated_mix__sliding_block_cached__glu_gated_swiglu__decode_kernel
.p2align 8
.type gated_mix__sliding_block_cached__glu_gated_swiglu__decode_kernel,@function
gated_mix__sliding_block_cached__glu_gated_swiglu__decode_kernel:
    s_load_dwordx16 s[4:19], s[0:1], 0
    s_load_dwordx8 s[20:27], s[0:1], 64
    s_load_dwordx2 s[28:29], s[0:1], 96
    v_lshrrev_b32 v2, 6, v0
    s_cmp_ge_u32 s2, 256
    v_readfirstlane_b32 s3, v2
    s_cbranch_scc1 L_end
    v_mov_b32 v1, 155648
    v_and_b32 v0, 63, v0
    s_and_b32 s44, s2, 7
    s_lshr_b32 s45, s2, 3
    s_sub_u32 s3, s3, 1
    s_cbranch_scc1 L_loader
    s_getpc_b64 s[64:65]
L_pc:
    s_lshl2_add_u32 s49, s45, s3
    s_lshl_b32 s49, s49, 6
    s_min_u32 s49, s49, L_end - L_pc
    s_load_dword s66, s[64:65], s49
    s_barrier
    s_branch L_compute
L_loader:
    s_and_b32 s49, s45, 28
    s_lshl_b32 s49, s49, 1
    s_add_u32 s49, s49, s44
    s_sub_u32 s49, s49, 32
    s_cmp_lt_u32 s49, 28
    s_cselect_b32 s34, 1835008, 0
    s_lshr_b32 s50, s45, 1
    s_lshl3_add_u32 s50, s44, s50
    s_movk_i32 s53, 3584
    s_cmp_lt_u32 s45, 16
    s_cselect_b32 s34, 4194304, s34
    s_cselect_b32 s54, s50, s49
    s_cselect_b32 s53, 8192, s53
    s_and_b32 s60, s45, 1
    s_mul_i32 s49, s53, s60
    s_lshl1_add_u32 s54, s49, s54
    s_lshl_b32 s54, s54, 7
    s_lshl_b32 s58, s53, 3
    s_mov_b32 s35, 0x20000
    s_mov_b32 m0, 98304
    v_lshrrev_b32 v5, 3, v0
    v_and_b32 v6, 6, v5
    v_and_b32 v7, 7, v0
    v_xor_b32 v6, v6, v7
    v_lshlrev_b32 v6, 4, v6
    v_mad_u32_u24 v8, v5, s53, v6
    v_lshl_add_u32 v3, v0, 2, v1
    v_mov_b32 v4, 0xff800000
    v_cmp_gt_u32 vcc, 8, v0
    s_mov_b64 exec, 0xfff
    s_lshl_b32 s61, s44, 5
    v_cndmask_b32 v4, v4, 0, vcc
    ds_write_b32 v3, v4
    s_mov_b64 exec, -1
    s_add_u32 s61, s61, s45
    s_lshl_b32 s70, s61, 7
    s_add_u32 s70, s70, 819200
    s_lshl2_add_u32 s71, s61, 811008
    s_mov_b32 s42, 1572864
    s_mov_b32 s43, 0x20000
    s_lshl_b32 s62, s61, 11
    s_lshl_b32 s63, s61, 10
    s_add_u32 s63, s63, 524288
    s_lshl_b32 s61, s61, 5
    s_add_u32 s61, s61, 786432
    s_and_b32 s47, s45, 7
    s_lshr_b32 s46, s45, 3
    v_lshlrev_b32 v16, 4, v0
    v_mov_b32 v20, -1
    v_mov_b32 v21, -1
    v_mov_b32 v22, -1
    v_mov_b32 v23, -1
    v_mov_b32 v3, -24
    s_bitcmp1_b32 s45, 1
    s_waitcnt lgkmcnt(0)
    s_barrier
    s_cselect_b64 s[32:33], s[18:19], s[16:17]
    s_cmp_lt_u32 s45, 16
    s_cselect_b64 s[32:33], s[10:11], s[32:33]
    s_load_dword s65, s[28:29], s71
    s_mov_b64 s[40:41], s[28:29]
    buffer_store_dwordx4 v[20:23], v16, s[40:43], s62 offen
    buffer_store_dwordx4 v[20:23], v16, s[40:43], s62 offen offset:1024
    buffer_store_dwordx4 v[20:23], v16, s[40:43], s63 offen
    s_mov_b64 exec, 3
    buffer_store_dwordx4 v[20:23], v16, s[40:43], s61 offen
    s_mov_b64 exec, -1
    s_mov_b32 s59, 6
LD_1:
    buffer_load_dwordx4 v8, s[32:35], s54 offen nt lds
    s_add_u32 m0, m0, 1024
    s_add_u32 s54, s54, s58
    buffer_load_dwordx4 v8, s[32:35], s54 offen nt lds
    s_add_u32 m0, m0, 1024
    s_add_u32 s54, s54, s58
    buffer_load_dwordx4 v8, s[32:35], s54 offen nt lds
    s_add_u32 m0, m0, 1024
    s_add_u32 s54, s54, s58
    buffer_load_dwordx4 v8, s[32:35], s54 offen nt lds
    s_add_u32 m0, m0, 1024
    s_add_u32 s54, s54, s58
    s_sub_u32 s59, s59, 1
    s_cmp_lg_u32 s59, 0
    s_cbranch_scc1 LD_1
    v_add_u32 v3, 28, v3
    buffer_load_dwordx4 v8, s[32:35], s54 offen nt lds
    s_add_u32 m0, m0, 1024
    s_add_u32 s54, s54, s58
    buffer_load_dwordx4 v8, s[32:35], s54 offen nt lds
    s_add_u32 m0, m0, 1024
    s_add_u32 s54, s54, s58
    buffer_load_dwordx4 v8, s[32:35], s54 offen nt lds
    s_add_u32 m0, m0, 1024
    s_add_u32 s54, s54, s58
    buffer_load_dwordx4 v8, s[32:35], s54 offen nt lds
    s_add_u32 m0, m0, 1024
    s_add_u32 s54, s54, s58
    s_waitcnt vmcnt(24)
    v_add_u32 v3, 4, v3
    ds_write_b32 v1, v3 offset:0
    s_getreg_b32 s66, hwreg(HW_REG_XCC_ID, 0, 3)
    s_waitcnt lgkmcnt(0)
    v_mov_b32 v25, s65
    s_add_u32 s65, s65, s66
    s_add_u32 s65, s65, 1
    v_mov_b32 v24, s65
    v_mov_b32 v26, v25
    v_mov_b32 v27, v25
    s_mov_b64 exec, 0xff
    buffer_store_dwordx4 v[24:27], v16, s[40:43], s70 offen
    s_mov_b64 exec, -1
    v_add_u32 v3, 1, v3
    buffer_load_dwordx4 v8, s[32:35], s54 offen nt lds
    s_add_u32 m0, m0, 1024
    s_add_u32 s54, s54, s58
    buffer_load_dwordx4 v8, s[32:35], s54 offen nt lds
    s_add_u32 m0, m0, 1024
    s_add_u32 s54, s54, s58
    buffer_load_dwordx4 v8, s[32:35], s54 offen nt lds
    s_add_u32 m0, m0, 1024
    s_add_u32 s54, s54, s58
    buffer_load_dwordx4 v8, s[32:35], s54 offen nt lds
    s_add_u32 m0, m0, 1024
    s_add_u32 s54, s54, s58
    s_waitcnt vmcnt(24)
    v_add_u32 v3, 4, v3
    ds_write_b32 v1, v3 offset:0
    s_mov_b64 s[36:37], s[4:5]
    s_mov_b32 s38, 8192
    s_mov_b32 s39, 0x20000
    v_lshrrev_b32 v4, 5, v0
    v_and_b32 v7, 31, v0
    v_lshlrev_b32 v7, 4, v7
    v_lshl_add_u32 v4, v4, 10, v7
    v_lshl_add_u32 v9, v5, 10, v6
    s_lshl_b32 s50, s60, 9
    s_mov_b32 m0, 131072
    s_nop 0
    buffer_load_dwordx4 v4, s[36:39], s50 offen lds
    s_add_u32 m0, m0, 1040
    s_add_u32 s50, s50, 2048
    buffer_load_dwordx4 v4, s[36:39], s50 offen lds
    s_add_u32 m0, m0, 1040
    s_add_u32 s50, s50, 2048
    buffer_load_dwordx4 v4, s[36:39], s50 offen lds
    s_add_u32 m0, m0, 1040
    s_add_u32 s50, s50, 2048
    buffer_load_dwordx4 v4, s[36:39], s50 offen lds
    s_add_u32 m0, m0, 1040
    s_add_u32 s50, s50, 2048
    s_waitcnt vmcnt(24)
    v_add_u32 v3, 4, v3
    ds_write_b32 v1, v3 offset:0
    s_xor_b32 s50, s60, 1
    s_lshl_b32 s50, s50, 9
    buffer_load_dwordx4 v4, s[36:39], s50 offen lds
    s_add_u32 m0, m0, 1040
    s_add_u32 s50, s50, 2048
    buffer_load_dwordx4 v4, s[36:39], s50 offen lds
    s_add_u32 m0, m0, 1040
    s_add_u32 s50, s50, 2048
    buffer_load_dwordx4 v4, s[36:39], s50 offen lds
    s_add_u32 m0, m0, 1040
    s_add_u32 s50, s50, 2048
    buffer_load_dwordx4 v4, s[36:39], s50 offen lds
    s_add_u32 m0, m0, 1040
    s_add_u32 s50, s50, 2048
    s_mov_b64 s[36:37], s[22:23]
    s_mov_b32 s38, 1024
    s_mov_b32 s39, 0x20000
    buffer_load_dwordx4 v16, s[36:39], 0 offen lds
    s_waitcnt vmcnt(24)
    v_add_u32 v3, 5, v3
    ds_write_b32 v1, v3 offset:0
    s_mov_b64 s[36:37], s[6:7]
    s_mov_b32 s38, 67108864
    s_mov_b32 s39, 0x20000
    s_lshr_b32 s55, s45, 2
    s_lshl3_add_u32 s55, s55, s44
    s_lshl_b32 s55, s55, 4
    s_and_b32 s49, s45, 3
    s_add_u32 s55, s55, s49
    s_add_u32 s55, s55, 12
    s_lshl_b32 s55, s55, 16
    v_lshrrev_b32 v5, 4, v0
    v_and_b32 v7, 15, v0
    v_xor_b32 v6, v7, v5
    v_lshlrev_b32 v6, 4, v6
    v_lshl_add_u32 v10, v5, 8, v6
    v_xor_b32 v11, 64, v10
    v_xor_b32 v12, 0x80, v10
    v_xor_b32 v13, 0xc0, v10
    v_lshlrev_b32 v6, 1, v5
    v_xor_b32 v6, v7, v6
    v_lshlrev_b32 v6, 4, v6
    v_lshl_add_u32 v14, v5, 8, v6
    v_xor_b32 v15, 0x80, v14
    s_lshl_b32 s67, s45, 12
    s_mov_b32 m0, 0
    s_mov_b32 s59, 4
LD_2:
    s_and_b32 s67, s67, 0xffff
    s_add_u32 s54, s55, s67
    buffer_load_dwordx4 v10, s[36:39], s54 offen offset:0 nt lds
    buffer_load_dwordx4 v11, s[36:39], s54 offen offset:1024 nt lds
    buffer_load_dwordx4 v12, s[36:39], s54 offen offset:2048 nt lds
    buffer_load_dwordx4 v13, s[36:39], s54 offen offset:3072 nt lds
    s_add_u32 m0, m0, 4096
    s_add_u32 s67, s67, 4096
    s_waitcnt vmcnt(24)
    v_add_u32 v3, 4, v3
    ds_write_b32 v1, v3 offset:0
    s_sub_u32 s59, s59, 1
    s_cmp_lg_u32 s59, 0
    s_cbranch_scc1 LD_2
    s_mov_b32 s71, 811008
    s_mov_b32 s69, m0
    s_mov_b32 m0, 160256
    v_lshlrev_b32 v17, 7, v0
    buffer_load_dwordx4 v16, s[40:43], s71 offen lds
    s_mov_b32 m0, 161280
    s_lshl_b32 s71, s44, 12
    s_add_u32 s71, s71, 819200
    s_mov_b32 exec_hi, 0
    buffer_load_dword v17, s[40:43], s71 offen sc1 lds
    s_mov_b64 exec, -1
    s_mov_b32 m0, s69
    v_add_u32 v3, 2, v3
    s_mov_b32 s59, 12
LD_3:
    s_and_b32 s67, s67, 0xffff
    s_add_u32 s54, s55, s67
    buffer_load_dwordx4 v10, s[36:39], s54 offen offset:0 nt lds
    buffer_load_dwordx4 v11, s[36:39], s54 offen offset:1024 nt lds
    buffer_load_dwordx4 v12, s[36:39], s54 offen offset:2048 nt lds
    buffer_load_dwordx4 v13, s[36:39], s54 offen offset:3072 nt lds
    s_add_u32 m0, m0, 4096
    s_add_u32 s67, s67, 4096
    s_waitcnt vmcnt(24)
    v_add_u32 v3, 4, v3
    ds_write_b32 v1, v3 offset:0
    s_sub_u32 s59, s59, 1
    s_cmp_lg_u32 s59, 0
    s_cbranch_scc1 LD_3
    s_mov_b64 s[36:37], s[8:9]
    s_mov_b32 m0, 65536
    s_lshl_b32 s49, s47, 7
    s_lshl2_add_u32 s56, s44, s46
    s_lshl_b32 s56, s56, 17
    s_add_u32 s56, s56, s49
    s_lshl3_add_u32 s52, s46, s44
    s_lshl_b32 s57, s52, 16
    s_add_u32 s57, s57, s49
    s_mov_b64 s[32:33], s[20:21]
    s_cmp_lt_u32 s52, 28
    s_cselect_b32 s34, 1835008, 0
    s_mov_b32 s68, 147456
    s_mov_b32 s59, 3
LD_4:
    s_and_b32 s67, s67, 0xffff
    s_add_u32 s54, s55, s67
    buffer_load_dwordx4 v14, s[36:39], s54 offen offset:0 nt lds
    buffer_load_dwordx4 v15, s[36:39], s54 offen offset:1024 nt lds
    buffer_load_dwordx4 v14, s[36:39], s54 offen offset:2048 nt lds
    buffer_load_dwordx4 v15, s[36:39], s54 offen offset:3072 nt lds
    s_add_u32 m0, m0, 4096
    s_add_u32 s67, s67, 4096
    s_mov_b32 s69, m0
    s_mov_b32 m0, s68
    s_add_u32 s68, s68, 1024
    buffer_load_dwordx4 v9, s[32:35], s57 offen nt lds
    s_add_u32 s57, s57, 8192
    s_mov_b32 m0, s68
    s_add_u32 s68, s68, 1024
    buffer_load_dwordx4 v9, s[32:35], s57 offen nt lds
    s_add_u32 s57, s57, 8192
    s_mov_b32 m0, s69
    s_waitcnt vmcnt(24)
    v_add_u32 v3, 6, v3
    ds_write_b32 v1, v3 offset:0
    s_sub_u32 s59, s59, 1
    s_cmp_lg_u32 s59, 0
    s_cbranch_scc1 LD_4
    s_lshl2_add_u32 s71, s47, s46
    s_lshl_b32 s49, s44, 5
    s_add_u32 s71, s71, s49
    s_lshl_b32 s71, s71, 11
    s_add_u32 s71, s71, 1048576
    s_mov_b32 s69, m0
    s_mov_b32 m0, 161792
    s_nop 0
    buffer_load_dwordx4 v16, s[40:43], s71 offen lds
    buffer_load_dwordx4 v16, s[40:43], s71 offen offset:1024 lds
    s_mov_b32 m0, s69
    v_add_u32 v3, 2, v3
    s_and_b32 s67, s67, 0xffff
    s_add_u32 s54, s55, s67
    buffer_load_dwordx4 v14, s[36:39], s54 offen offset:0 nt lds
    buffer_load_dwordx4 v15, s[36:39], s54 offen offset:1024 nt lds
    buffer_load_dwordx4 v14, s[36:39], s54 offen offset:2048 nt lds
    buffer_load_dwordx4 v15, s[36:39], s54 offen offset:3072 nt lds
    s_add_u32 m0, m0, 4096
    s_add_u32 s67, s67, 4096
    s_mov_b32 s69, m0
    s_mov_b32 m0, s68
    s_add_u32 s68, s68, 1024
    buffer_load_dwordx4 v9, s[32:35], s57 offen nt lds
    s_add_u32 s57, s57, 8192
    s_mov_b32 m0, s68
    s_add_u32 s68, s68, 1024
    buffer_load_dwordx4 v9, s[32:35], s57 offen nt lds
    s_add_u32 s57, s57, 8192
    s_mov_b32 m0, s69
    s_waitcnt vmcnt(24)
    v_add_u32 v3, 6, v3
    ds_write_b32 v1, v3 offset:0
    s_mov_b32 s59, 4
LD_5:
    s_and_b32 s67, s67, 0xffff
    s_add_u32 s54, s55, s67
    buffer_load_dwordx4 v14, s[36:39], s54 offen offset:0 nt lds
    buffer_load_dwordx4 v15, s[36:39], s54 offen offset:1024 nt lds
    buffer_load_dwordx4 v14, s[36:39], s54 offen offset:2048 nt lds
    buffer_load_dwordx4 v15, s[36:39], s54 offen offset:3072 nt lds
    s_add_u32 m0, m0, 4096
    s_add_u32 s67, s67, 4096
    s_waitcnt vmcnt(24)
    v_add_u32 v3, 4, v3
    ds_write_b32 v1, v3 offset:0
    s_sub_u32 s59, s59, 1
    s_cmp_lg_u32 s59, 0
    s_cbranch_scc1 LD_5
L_waitA:
    ds_read_b32 v2, v1 offset:8
    s_waitcnt lgkmcnt(0)
    v_readfirstlane_b32 s49, v2
    s_cmp_ge_u32 s49, 4
    s_cbranch_scc0 L_waitA
    s_mov_b32 s59, 8
LD_6:
    s_and_b32 s67, s67, 0xffff
    s_add_u32 s54, s55, s67
    buffer_load_dwordx4 v14, s[36:39], s54 offen offset:0 nt lds
    buffer_load_dwordx4 v15, s[36:39], s54 offen offset:1024 nt lds
    buffer_load_dwordx4 v14, s[36:39], s54 offen offset:2048 nt lds
    buffer_load_dwordx4 v15, s[36:39], s54 offen offset:3072 nt lds
    s_add_u32 m0, m0, 4096
    s_add_u32 s67, s67, 4096
    s_waitcnt vmcnt(24)
    v_add_u32 v3, 4, v3
    ds_write_b32 v1, v3 offset:0
    s_sub_u32 s59, s59, 1
    s_cmp_lg_u32 s59, 0
    s_cbranch_scc1 LD_6
    s_mov_b64 s[32:33], s[12:13]
    s_mov_b32 s34, 4194304
    s_mov_b32 s35, 0x20000
    s_mov_b32 s58, 8192
    s_mov_b32 s68, 131072
    s_mov_b32 s69, m0
    s_mov_b32 m0, s68
    s_mov_b32 s54, s56
    s_mov_b32 s59, 4
LD_7:
    buffer_load_dwordx4 v9, s[32:35], s54 offen nt lds
    s_add_u32 m0, m0, 1024
    s_add_u32 s54, s54, s58
    buffer_load_dwordx4 v9, s[32:35], s54 offen nt lds
    s_add_u32 m0, m0, 1024
    s_add_u32 s54, s54, s58
    buffer_load_dwordx4 v9, s[32:35], s54 offen nt lds
    s_add_u32 m0, m0, 1024
    s_add_u32 s54, s54, s58
    buffer_load_dwordx4 v9, s[32:35], s54 offen nt lds
    s_add_u32 m0, m0, 1024
    s_add_u32 s54, s54, s58
    s_waitcnt vmcnt(24)
    v_add_u32 v3, 4, v3
    ds_write_b32 v1, v3 offset:0
    s_sub_u32 s59, s59, 1
    s_cmp_lg_u32 s59, 0
    s_cbranch_scc1 LD_7
    s_waitcnt vmcnt(20)
    v_add_u32 v3, 4, v3
    ds_write_b32 v1, v3 offset:0
    s_waitcnt vmcnt(16)
    s_barrier
    s_waitcnt vmcnt(4)
    s_barrier
    s_waitcnt vmcnt(0)
    s_barrier
    s_endpgm
L_compute:
    s_lshr_b32 s46, s45, 3
    s_and_b32 s47, s45, 7
    s_lshr_b32 s48, s45, 2
    s_lshl_b32 s53, s44, 5
    s_add_u32 s53, s53, s45
    s_and_b32 s54, s3, 1
    s_lshr_b32 s55, s3, 1
    s_lshl2_add_u32 s56, s44, s46
    v_mov_b32 v12, 1
    v_and_b32 v3, 15, v0
    v_lshrrev_b32 v4, 4, v0
    v_lshlrev_b32 v9, 4, v4
    s_lshl_b32 s57, s53, 5
    s_add_u32 s57, s57, s3
    s_lshl_b32 s57, s57, 6
    v_lshl_add_u32 v5, v3, 8, v9
    v_and_b32 v11, 1, v3
    v_bfe_u32 v10, v3, 1, 2
    v_mul_u32_u24 v16, 1040, v10
    v_lshl_add_u32 v16, v11, 9, v16
    v_lshl_add_u32 v16, v4, 3, v16
    v_add_u32 v16, 131072, v16
    s_lshl_b32 s60, s54, 5
    s_add_u32 s60, s60, s47
    s_lshl1_add_u32 s60, s60, s55
    s_lshl_b32 s60, s60, 6
    s_add_u32 s60, s60, s56
    s_lshl_b32 s60, s60, 6
    s_add_u32 s60, s60, 1048576
    v_lshrrev_b32 v10, 2, v3
    v_lshl_add_u32 v8, v10, 16, v9
    v_lshl_add_u32 v8, v11, 11, v8
    v_cmp_eq_u32 s[74:75], 1, v11
    v_lshl_add_u32 v10, v4, 2, v10
    v_bfe_u32 v29, v3, 1, 1
    v_lshlrev_b32 v11, 3, v11
    v_and_b32 v30, 6, v10
    v_xor_b32 v30, v30, v29
    v_lshl_add_u32 v30, v30, 4, v11
    v_lshl_add_u32 v30, v10, 7, v30
    s_lshl_b32 s49, s3, 5
    v_xor_b32 v19, s49, v30
    v_add_u32 v19, 98304, v19
    s_lshl_b32 s49, s55, 6
    v_xor_b32 v17, s49, v30
    v_add_u32 v17, 131072, v17
    v_xor_b32 v18, 32, v17
    v_and_b32 v30, 7, v10
    v_lshlrev_b32 v30, 1, v30
    v_xor_b32 v30, v30, v29
    v_lshl_add_u32 v30, v30, 4, v11
    v_lshl_add_u32 v30, v10, 8, v30
    s_lshl_b32 s49, s3, 6
    v_xor_b32 v24, s49, v30
    v_add_u32 v24, 65536, v24
    v_xor_b32 v25, 32, v24
    v_xor_b32 v30, v4, v3
    v_lshlrev_b32 v30, 4, v30
    v_lshl_add_u32 v30, v3, 8, v30
    s_lshl_b32 s49, s3, 12
    v_add_u32 v20, s49, v30
    v_xor_b32 v21, 64, v20
    v_xor_b32 v22, 0x80, v20
    v_xor_b32 v23, 0xc0, v20
    v_and_b32 v30, 3, v3
    v_mul_u32_u24 v26, 272, v30
    v_add3_u32 v26, v26, v9, v1
    v_lshl_add_u32 v27, v30, 6, v9
    v_add_u32 v27, v27, v1
    v_lshlrev_b32 v14, 3, v30
    v_lshl_add_u32 v14, v4, 1, v14
    v_lshrrev_b32 v30, 2, v3
    s_lshl_b32 s49, s54, 2
    v_add_u32 v31, s49, v30
    v_mul_u32_u24 v28, 144, v31
    v_lshl_add_u32 v28, v4, 3, v28
    v_add_u32 v28, v28, v1
    v_lshl_add_u32 v31, v31, 2, v1
    s_mul_i32 s49, s3, 1040
    s_add_u32 s49, s49, 131072
    v_lshlrev_b32 v13, 4, v0
    v_add_u32 v102, s49, v13
    v_and_b32 v103, 0x1ff, v13
    s_and_b32 s49, s45, 1
    s_lshl_b32 s49, s49, 9
    v_add_u32 v103, s49, v103
    v_xor_b32 v104, 0x200, v103
    v_add_u32 v103, 139392, v103
    v_add_u32 v104, 139392, v104
    v_and_b32 v105, 31, v0
    v_lshlrev_b32 v101, 7, v105
    v_lshlrev_b32 v105, 3, v105
    v_lshrrev_b32 v106, 5, v0
    v_lshl_add_u32 v105, v106, 12, v105
    v_lshlrev_b32 v106, 3, v0
    s_lshl4_add_u32 s58, s44, s3
    s_lshl_b32 s58, s58, 5
    s_add_u32 s58, s58, s45
    s_lshl_b32 s58, s58, 6
    s_add_u32 s58, s58, 524288
    v_lshl_add_u32 v6, v3, 13, v9
    s_lshl_b32 s59, s44, 7
    s_add_u32 s59, s59, s45
    s_lshl3_add_u32 s59, s59, 786432
    v_lshlrev_b32 v7, 8, v3
    s_lshl3_add_u32 s68, s56, s54
    s_lshl_b32 s68, s68, 10
    s_add_u32 s68, s68, 524288
    s_add_u32 s70, s68, 4096
    s_lshl1_add_u32 s69, s56, s54
    s_lshl_b32 s69, s69, 7
    s_add_u32 s69, s69, 786432
    v_lshl_add_u32 v197, v3, 6, v9
    v_lshlrev_b32 v198, 3, v3
    s_lshl3_add_u32 s73, s44, s47
    s_lshl2_add_u32 s73, s73, s46
    s_lshl_b32 s72, s73, 11
    s_add_u32 s72, s72, 1048576
    s_lshl_b32 s73, s73, 5
    s_getreg_b32 s61, hwreg(HW_REG_XCC_ID, 0, 3)
    s_add_u32 s61, s61, 1
    s_lshl_b32 s63, s44, 12
    s_add_u32 s63, s63, 819200
    s_mov_b32 s62, 2000000
    s_mov_b32 s67, 0x3e0293ee
    s_movk_i32 s78, 0x3ff
    s_waitcnt lgkmcnt(0)
    s_lshl3_add_u32 s64, s44, s3
    s_lshl_b32 s64, s64, 5
    s_add_u32 s64, s64, s48
    s_lshl_b32 s64, s64, 8
    s_lshl3_add_u32 s65, s44, s46
    s_lshl4_add_u32 s65, s65, s3
    s_lshl_b32 s65, s65, 9
    s_add_u32 s65, s65, 32768
    s_add_u32 s66, s65, 4096
    s_mov_b64 s[40:41], s[28:29]
    s_mov_b32 s42, 1572864
    s_mov_b32 s43, 0x20000
    s_mov_b64 s[36:37], s[24:25]
    s_mov_b32 s38, 8192
    s_mov_b32 s39, 0x20000
W_8:
    ds_read_b32 v2, v1 offset:0
    s_waitcnt lgkmcnt(0)
    v_readfirstlane_b32 s49, v2
    s_cmp_ge_i32 s49, 41
    s_cbranch_scc0 W_8
    ds_read_b64_tr_b16 v[32:33], v19 offset:0
    ds_read_b64_tr_b16 v[34:35], v19 offset:2048
    ds_read2_b64 v[64:67], v16 offset0:0 offset1:4
    ds_read_b64_tr_b16 v[36:37], v19 offset:4096
    ds_read_b64_tr_b16 v[38:39], v19 offset:6144
    ds_read2_b64 v[68:71], v16 offset0:8 offset1:12
    ds_read_b64_tr_b16 v[40:41], v19 offset:8192
    ds_read_b64_tr_b16 v[42:43], v19 offset:10240
    ds_read2_b64 v[72:75], v16 offset0:16 offset1:20
    ds_read_b64_tr_b16 v[44:45], v19 offset:12288
    ds_read_b64_tr_b16 v[46:47], v19 offset:14336
    ds_read2_b64 v[76:79], v16 offset0:24 offset1:28
    s_waitcnt lgkmcnt(9)
    v_mfma_f32_16x16x32_bf16 v[96:99], v[32:35], v[64:67], 0
    ds_read_b64_tr_b16 v[48:49], v19 offset:16384
    ds_read_b64_tr_b16 v[50:51], v19 offset:18432
    ds_read2_b64 v[80:83], v16 offset0:32 offset1:36
    s_waitcnt lgkmcnt(9)
    v_mfma_f32_16x16x32_bf16 v[96:99], v[36:39], v[68:71], v[96:99]
    ds_read_b64_tr_b16 v[52:53], v19 offset:20480
    ds_read_b64_tr_b16 v[54:55], v19 offset:22528
    ds_read2_b64 v[84:87], v16 offset0:40 offset1:44
    s_waitcnt lgkmcnt(9)
    v_mfma_f32_16x16x32_bf16 v[96:99], v[40:43], v[72:75], v[96:99]
    ds_read_b64_tr_b16 v[56:57], v19 offset:24576
    ds_read_b64_tr_b16 v[58:59], v19 offset:26624
    ds_read2_b64 v[88:91], v16 offset0:48 offset1:52
    s_waitcnt lgkmcnt(9)
    v_mfma_f32_16x16x32_bf16 v[96:99], v[44:47], v[76:79], v[96:99]
    ds_read_b64_tr_b16 v[60:61], v19 offset:28672
    ds_read_b64_tr_b16 v[62:63], v19 offset:30720
    ds_read2_b64 v[92:95], v16 offset0:56 offset1:60
    s_waitcnt lgkmcnt(9)
    v_mfma_f32_16x16x32_bf16 v[96:99], v[48:51], v[80:83], v[96:99]
    s_waitcnt lgkmcnt(6)
    v_mfma_f32_16x16x32_bf16 v[96:99], v[52:55], v[84:87], v[96:99]
    s_waitcnt lgkmcnt(3)
    v_mfma_f32_16x16x32_bf16 v[96:99], v[56:59], v[88:91], v[96:99]
    s_waitcnt lgkmcnt(0)
    v_mfma_f32_16x16x32_bf16 v[96:99], v[60:63], v[92:95], v[96:99]
    s_mov_b32 exec_lo, 0xff00ff
    s_mov_b32 exec_hi, 0xff00ff
    s_nop 5
    buffer_store_dwordx4 v[96:99], v5, s[40:43], s57 offen
    s_mov_b64 exec, -1
W_9:
    ds_read_b32 v2, v1 offset:0
    s_waitcnt lgkmcnt(0)
    v_readfirstlane_b32 s49, v2
    s_cmp_ge_i32 s49, 46
    s_cbranch_scc0 W_9
    ds_read_b128 v[32:35], v102
    ds_read_b128 v[36:39], v102 offset:4160
    ds_read_b128 v[40:43], v103
    ds_read_b128 v[44:47], v104
    s_mov_b64 exec, 1
    ds_add_u32 v1, v12 offset:8
    s_mov_b64 exec, -1
    s_waitcnt lgkmcnt(0)
    v_lshlrev_b32 v54, 16, v32
    v_and_b32 v55, 0xffff0000, v32
    v_lshlrev_b32 v56, 16, v40
    v_and_b32 v57, 0xffff0000, v40
    v_mul_f32 v54, v54, v56
    v_mul_f32 v55, v55, v57
    v_cvt_pk_bf16_f32 v54, v54, v55
    v_and_b32 v55, 0xffff0000, v54
    v_lshlrev_b32 v54, 16, v54
    v_add_f32 v52, v54, v55
    v_lshlrev_b32 v54, 16, v33
    v_and_b32 v55, 0xffff0000, v33
    v_lshlrev_b32 v56, 16, v41
    v_and_b32 v57, 0xffff0000, v41
    v_mul_f32 v54, v54, v56
    v_mul_f32 v55, v55, v57
    v_cvt_pk_bf16_f32 v54, v54, v55
    v_and_b32 v55, 0xffff0000, v54
    v_lshlrev_b32 v54, 16, v54
    v_add_f32 v52, v52, v54
    v_add_f32 v52, v52, v55
    v_lshlrev_b32 v54, 16, v34
    v_and_b32 v55, 0xffff0000, v34
    v_lshlrev_b32 v56, 16, v42
    v_and_b32 v57, 0xffff0000, v42
    v_mul_f32 v54, v54, v56
    v_mul_f32 v55, v55, v57
    v_cvt_pk_bf16_f32 v54, v54, v55
    v_and_b32 v55, 0xffff0000, v54
    v_lshlrev_b32 v54, 16, v54
    v_add_f32 v52, v52, v54
    v_add_f32 v52, v52, v55
    v_lshlrev_b32 v54, 16, v35
    v_and_b32 v55, 0xffff0000, v35
    v_lshlrev_b32 v56, 16, v43
    v_and_b32 v57, 0xffff0000, v43
    v_mul_f32 v54, v54, v56
    v_mul_f32 v55, v55, v57
    v_cvt_pk_bf16_f32 v54, v54, v55
    v_and_b32 v55, 0xffff0000, v54
    v_lshlrev_b32 v54, 16, v54
    v_add_f32 v52, v52, v54
    v_add_f32 v52, v52, v55
    v_lshlrev_b32 v54, 16, v36
    v_and_b32 v55, 0xffff0000, v36
    v_lshlrev_b32 v56, 16, v44
    v_and_b32 v57, 0xffff0000, v44
    v_mul_f32 v54, v54, v56
    v_mul_f32 v55, v55, v57
    v_cvt_pk_bf16_f32 v54, v54, v55
    v_and_b32 v55, 0xffff0000, v54
    v_lshlrev_b32 v54, 16, v54
    v_add_f32 v52, v52, v54
    v_add_f32 v52, v52, v55
    v_lshlrev_b32 v54, 16, v37
    v_and_b32 v55, 0xffff0000, v37
    v_lshlrev_b32 v56, 16, v45
    v_and_b32 v57, 0xffff0000, v45
    v_mul_f32 v54, v54, v56
    v_mul_f32 v55, v55, v57
    v_cvt_pk_bf16_f32 v54, v54, v55
    v_and_b32 v55, 0xffff0000, v54
    v_lshlrev_b32 v54, 16, v54
    v_add_f32 v52, v52, v54
    v_add_f32 v52, v52, v55
    v_lshlrev_b32 v54, 16, v38
    v_and_b32 v55, 0xffff0000, v38
    v_lshlrev_b32 v56, 16, v46
    v_and_b32 v57, 0xffff0000, v46
    v_mul_f32 v54, v54, v56
    v_mul_f32 v55, v55, v57
    v_cvt_pk_bf16_f32 v54, v54, v55
    v_and_b32 v55, 0xffff0000, v54
    v_lshlrev_b32 v54, 16, v54
    v_add_f32 v52, v52, v54
    v_add_f32 v52, v52, v55
    v_lshlrev_b32 v54, 16, v39
    v_and_b32 v55, 0xffff0000, v39
    v_lshlrev_b32 v56, 16, v47
    v_and_b32 v57, 0xffff0000, v47
    v_mul_f32 v54, v54, v56
    v_mul_f32 v55, v55, v57
    v_cvt_pk_bf16_f32 v54, v54, v55
    v_and_b32 v55, 0xffff0000, v54
    v_lshlrev_b32 v54, 16, v54
    v_add_f32 v52, v52, v54
    v_add_f32 v52, v52, v55
    s_nop 1
    v_add_f32_dpp v52, v52, v52 row_shr:1 bound_ctrl:0
    s_nop 1
    v_add_f32_dpp v52, v52, v52 row_shr:2 bound_ctrl:0
    s_nop 1
    v_add_f32_dpp v52, v52, v52 row_shr:4 bound_ctrl:0
    s_nop 1
    v_add_f32_dpp v52, v52, v52 row_shr:8 bound_ctrl:0
    s_nop 1
    v_add_f32_dpp v52, v52, v52 row_bcast:15 row_mask:0xa
    v_cvt_pk_bf16_f32 v52, v52, v52
    v_lshlrev_b32 v52, 16, v52
    v_mul_f32 v52, 0xbfb8aa3b, v52
    v_exp_f32 v52, v52
    s_lshl_b32 s49, s3, 3
    v_add_f32 v52, 1.0, v52
    v_rcp_f32 v52, v52
    v_lshrrev_b32 v30, 5, v0
    v_cvt_pk_bf16_f32 v52, v52, v52
    v_lshlrev_b32 v52, 16, v52
    v_lshl_add_u32 v30, v30, 2, v1
    v_add_u32 v30, s49, v30
    s_mov_b32 exec_lo, 0x80000000
    s_mov_b32 exec_hi, 0x80000000
    ds_write_b32 v30, v52 offset:64
    s_mov_b64 exec, -1
    v_and_b32 v35, 31, v0
    v_lshl_add_u32 v35, v35, 2, v1
    s_lshl_b32 s49, s44, 7
    v_add_u32 v36, s49, v35
    s_lshl3_add_u32 s49, s54, s55
    s_lshl4_add_u32 s49, s49, s47
    v_and_b32 v30, 1, v0
    v_lshrrev_b32 v37, 2, v3
    v_lshl_add_u32 v30, v37, 2, v30
    v_lshl_add_u32 v30, v30, 3, s49
    v_lshl_add_u32 v30, v30, 2, v1
W_10:
    ds_read_b32 v2, v1 offset:0
    ds_read_b32 v33, v35 offset:5632
    ds_read_b32 v32, v36 offset:4608
    ds_read_b32 v199, v30 offset:4608
    s_waitcnt lgkmcnt(0)
    v_readfirstlane_b32 s49, v2
    s_cmp_ge_i32 s49, 64
    s_cbranch_scc0 W_10
    v_readlane_b32 s77, v32, s45
    v_add_u32 v199, 1, v199
    v_sub_u32 v34, v33, v32
    v_cmp_eq_u32 vcc, s61, v34
    v_add_u32 v34, -1, v34
    s_cmp_eq_u32 vcc_lo, -1
    s_cselect_b32 s71, 1, 0
    v_cmp_gt_u32 vcc, 8, v34
    s_cmp_eq_u32 vcc_lo, -1
    s_cbranch_scc0 L_chkslow
L_chkback:
    s_add_u32 s76, s77, s61
    s_add_u32 s77, s77, 1
    s_and_b32 s77, s77, s78
    s_cmp_eq_u32 s71, 0
    s_cbranch_scc1 L_impure
L_pure:
L_gA:
    buffer_load_dwordx2 v[32:33], v105, s[40:43], s64 offen sc1
    buffer_load_dwordx2 v[34:35], v105, s[40:43], s64 offen offset:2048 sc1
    buffer_load_dwordx2 v[36:37], v106, s[40:43], s65 offen sc1
    buffer_load_dwordx2 v[38:39], v106, s[40:43], s65 offen offset:2048 sc1
    buffer_load_dwordx2 v[40:41], v106, s[40:43], s66 offen sc1
    buffer_load_dwordx2 v[42:43], v106, s[40:43], s66 offen offset:2048 sc1
    s_waitcnt vmcnt(0)
    v_max3_u32 v44, v32, v33, v34
    v_max3_u32 v45, v35, v36, v37
    v_max3_u32 v46, v38, v39, v40
    v_max3_u32 v47, v41, v42, v43
    v_max3_u32 v44, v44, v45, v46
    v_max_u32 v44, v44, v47
    v_cmp_eq_u32 vcc, -1, v44
    s_cbranch_vccz L_gAdone
    s_mov_b64 exec, vcc
    s_sub_u32 s62, s62, 1
    s_cbranch_scc0 L_gA
    s_mov_b32 s62, 0
L_gAdone:
    s_mov_b64 exec, -1
    v_add_f32 v32, v32, v34
    v_add_f32 v33, v33, v35
    v_cvt_pk_bf16_f32 v32, v32, v33
    s_mul_i32 s49, s3, 272
    v_lshl_add_u32 v30, v0, 2, v1
    v_add_u32 v30, s49, v30
    ds_write_b32 v30, v32 offset:128
    s_mov_b64 exec, 1
    ds_add_u32 v1, v12 offset:12
    s_mov_b64 exec, -1
    v_add_f32 v36, v36, v38
    v_add_f32 v37, v37, v39
    v_add_f32 v40, v40, v42
    v_add_f32 v41, v41, v43
    v_cvt_pk_bf16_f32 v36, v36, v37
    v_cvt_pk_bf16_f32 v40, v40, v41
    v_and_b32 v37, 0xffff0000, v36
    v_lshlrev_b32 v36, 16, v36
    v_and_b32 v41, 0xffff0000, v40
    v_lshlrev_b32 v40, 16, v40
    v_mul_f32 v38, 0xbfb8aa3b, v36
    v_mul_f32 v39, 0xbfb8aa3b, v37
    v_exp_f32 v38, v38
    v_exp_f32 v39, v39
    s_nop 0
    v_add_f32 v38, 1.0, v38
    v_add_f32 v39, 1.0, v39
    v_rcp_f32 v38, v38
    v_rcp_f32 v39, v39
    s_nop 0
    v_mul_f32 v36, v36, v38
    v_mul_f32 v37, v37, v39
    v_cvt_pk_bf16_f32 v36, v36, v37
    v_and_b32 v37, 0xffff0000, v36
    v_lshlrev_b32 v36, 16, v36
    v_mul_f32 v36, v36, v40
    v_mul_f32 v37, v37, v41
    v_cvt_pk_bf16_f32 v36, v36, v37
    v_lshrrev_b32 v29, 5, v0
    s_lshl_b32 s49, s3, 1
    v_add_u32 v29, s49, v29
    v_mul_u32_u24 v29, 144, v29
    v_and_b32 v30, 31, v0
    v_lshl_add_u32 v29, v30, 2, v29
    v_add_u32 v29, v29, v1
    ds_write_b32 v29, v36 offset:1280
    v_and_b32 v30, 3, v0
    v_lshl_add_u32 v30, v30, 2, v1
    s_lshl_b32 s49, s55, 5
    s_add_u32 s49, s49, s54
    s_lshl_b32 s49, s49, 3
    v_add_u32 v29, s49, v27
W_11:
    ds_read_b32 v2, v1 offset:0
    s_waitcnt lgkmcnt(0)
    v_readfirstlane_b32 s49, v2
    s_cmp_ge_i32 s49, 80
    s_cbranch_scc0 W_11
    ds_read_b128 v[32:35], v20 offset:0
    ds_read_b128 v[36:39], v21 offset:0
    ds_read_b128 v[40:43], v22 offset:0
    ds_read_b128 v[44:47], v23 offset:0
    ds_read_b128 v[48:51], v20 offset:16384
    ds_read_b128 v[52:55], v21 offset:16384
    ds_read_b128 v[56:59], v22 offset:16384
    ds_read_b128 v[60:63], v23 offset:16384
W_12:
    ds_read_b32 v2, v1 offset:12
    s_waitcnt lgkmcnt(0)
    v_readfirstlane_b32 s49, v2
    s_cmp_ge_i32 s49, 4
    s_cbranch_scc0 W_12
    ds_read_b128 v[96:99], v26 offset:128
    ds_read_b128 v[100:103], v26 offset:192
    ds_read_b128 v[104:107], v26 offset:256
    ds_read_b128 v[108:111], v26 offset:320
    s_waitcnt lgkmcnt(3)
    v_mfma_f32_16x16x32_bf16 v[112:115], v[32:35], v[96:99], 0
    v_mfma_f32_16x16x32_bf16 v[116:119], v[48:51], v[96:99], 0
    s_waitcnt lgkmcnt(2)
    v_mfma_f32_16x16x32_bf16 v[112:115], v[36:39], v[100:103], v[112:115]
    v_mfma_f32_16x16x32_bf16 v[116:119], v[52:55], v[100:103], v[116:119]
    s_waitcnt lgkmcnt(1)
    v_mfma_f32_16x16x32_bf16 v[112:115], v[40:43], v[104:107], v[112:115]
    v_mfma_f32_16x16x32_bf16 v[116:119], v[56:59], v[104:107], v[116:119]
    s_waitcnt lgkmcnt(0)
    v_mfma_f32_16x16x32_bf16 v[112:115], v[44:47], v[108:111], v[112:115]
    v_mfma_f32_16x16x32_bf16 v[116:119], v[60:63], v[108:111], v[116:119]
W_13:
    ds_read_b32 v2, v1 offset:0
    ds_read_b128 v[64:67], v20 offset:32768
    ds_read_b128 v[68:71], v21 offset:32768
    ds_read_b128 v[72:75], v22 offset:32768
    ds_read_b128 v[76:79], v23 offset:32768
    s_waitcnt lgkmcnt(0)
    v_readfirstlane_b32 s49, v2
    s_cmp_ge_i32 s49, 96
    s_cbranch_scc0 W_13
    v_mfma_f32_16x16x32_bf16 v[120:123], v[64:67], v[96:99], 0
    v_mfma_f32_16x16x32_bf16 v[120:123], v[68:71], v[100:103], v[120:123]
    v_mfma_f32_16x16x32_bf16 v[120:123], v[72:75], v[104:107], v[120:123]
    v_mfma_f32_16x16x32_bf16 v[120:123], v[76:79], v[108:111], v[120:123]
W_14:
    ds_read_b32 v2, v1 offset:0
    ds_read_b128 v[80:83], v20 offset:49152
    ds_read_b128 v[84:87], v21 offset:49152
    ds_read_b128 v[88:91], v22 offset:49152
    ds_read_b128 v[92:95], v23 offset:49152
    s_waitcnt lgkmcnt(0)
    v_readfirstlane_b32 s49, v2
    s_cmp_ge_i32 s49, 112
    s_cbranch_scc0 W_14
    v_mfma_f32_16x16x32_bf16 v[124:127], v[80:83], v[96:99], 0
    v_mfma_f32_16x16x32_bf16 v[124:127], v[84:87], v[100:103], v[124:127]
    v_mfma_f32_16x16x32_bf16 v[124:127], v[88:91], v[104:107], v[124:127]
    v_mfma_f32_16x16x32_bf16 v[124:127], v[92:95], v[108:111], v[124:127]
    v_max3_f32 v32, v112, v113, v114
    v_max3_f32 v33, v115, v116, v117
    v_max3_f32 v32, v32, v118, v119
    v_max3_f32 v33, v33, v120, v121
    v_max3_f32 v32, v32, v122, v123
    v_max_f32 v32, v32, v33
    s_mov_b32 exec_lo, 0xf000f
    s_mov_b32 exec_hi, 0xf000f
    v_max3_f32 v32, v32, v124, v125
    v_max3_f32 v32, v32, v126, v127
    ds_max_f32 v30, v32 offset:32
    s_mov_b64 exec, 1
    ds_add_u32 v1, v12 offset:16
    s_mov_b64 exec, -1
W_15:
    ds_read_b32 v2, v1 offset:16
    ds_read_b32 v32, v30 offset:32
    s_waitcnt lgkmcnt(0)
    v_readfirstlane_b32 s49, v2
    s_cmp_ge_i32 s49, 4
    s_cbranch_scc0 W_15
    v_mul_f32 v128, s67, v32
    v_fma_f32 v112, v112, s67, -v128
    v_fma_f32 v113, v113, s67, -v128
    v_fma_f32 v114, v114, s67, -v128
    v_fma_f32 v115, v115, s67, -v128
    v_fma_f32 v116, v116, s67, -v128
    v_fma_f32 v117, v117, s67, -v128
    v_fma_f32 v118, v118, s67, -v128
    v_fma_f32 v119, v119, s67, -v128
    v_fma_f32 v120, v120, s67, -v128
    v_fma_f32 v121, v121, s67, -v128
    v_fma_f32 v122, v122, s67, -v128
    v_fma_f32 v123, v123, s67, -v128
    v_fma_f32 v124, v124, s67, -v128
    v_fma_f32 v125, v125, s67, -v128
    v_fma_f32 v126, v126, s67, -v128
    v_fma_f32 v127, v127, s67, -v128
    v_exp_f32 v112, v112
    v_exp_f32 v113, v113
    v_exp_f32 v114, v114
    v_exp_f32 v115, v115
    v_exp_f32 v116, v116
    v_exp_f32 v117, v117
    v_exp_f32 v118, v118
    v_exp_f32 v119, v119
    v_exp_f32 v120, v120
    v_exp_f32 v121, v121
    v_exp_f32 v122, v122
    v_exp_f32 v123, v123
    v_exp_f32 v124, v124
    v_exp_f32 v125, v125
    v_exp_f32 v126, v126
    v_exp_f32 v127, v127
    s_mov_b32 exec_lo, 0xf000f
    s_mov_b32 exec_hi, 0xf000f
    v_cvt_pk_bf16_f32 v32, v112, v113
    v_cvt_pk_bf16_f32 v33, v114, v115
    v_cvt_pk_bf16_f32 v34, v116, v117
    v_cvt_pk_bf16_f32 v35, v118, v119
    v_cvt_pk_bf16_f32 v36, v120, v121
    v_cvt_pk_bf16_f32 v37, v122, v123
    v_cvt_pk_bf16_f32 v38, v124, v125
    v_cvt_pk_bf16_f32 v39, v126, v127
    ds_write_b64 v29, v[32:33] offset:2560
    ds_write_b64 v29, v[34:35] offset:3072
    ds_write_b64 v29, v[36:37] offset:3584
    ds_write_b64 v29, v[38:39] offset:4096
    s_mov_b64 exec, 1
    ds_add_u32 v1, v12 offset:20
    s_mov_b64 exec, -1
    v_mov_b32 v32, 0x3f803f80
    v_mov_b32 v33, 0x3f803f80
    v_mov_b32 v34, 0x3f803f80
    v_mov_b32 v35, 0x3f803f80
W_16:
    ds_read_b32 v2, v1 offset:20
    s_waitcnt lgkmcnt(0)
    v_readfirstlane_b32 s49, v2
    s_cmp_ge_i32 s49, 4
    s_cbranch_scc0 W_16
    ds_read_b128 v[96:99], v27 offset:2560
    ds_read_b128 v[100:103], v27 offset:2816
    ds_read_b128 v[104:107], v27 offset:3072
    ds_read_b128 v[108:111], v27 offset:3328
    ds_read_b128 v[112:115], v27 offset:3584
    ds_read_b128 v[116:119], v27 offset:3840
    ds_read_b128 v[120:123], v27 offset:4096
    ds_read_b128 v[124:127], v27 offset:4352
    s_cmp_eq_u32 s3, 0
    s_cbranch_scc0 L_nostat
    s_waitcnt lgkmcnt(0)
    v_mfma_f32_16x16x32_bf16 v[36:39], v[32:35], v[96:99], 0
    v_mfma_f32_16x16x32_bf16 v[36:39], v[32:35], v[100:103], v[36:39]
    v_mfma_f32_16x16x32_bf16 v[36:39], v[32:35], v[104:107], v[36:39]
    v_mfma_f32_16x16x32_bf16 v[36:39], v[32:35], v[108:111], v[36:39]
    v_mfma_f32_16x16x32_bf16 v[36:39], v[32:35], v[112:115], v[36:39]
    v_mfma_f32_16x16x32_bf16 v[36:39], v[32:35], v[116:119], v[36:39]
    v_mfma_f32_16x16x32_bf16 v[36:39], v[32:35], v[120:123], v[36:39]
    v_mfma_f32_16x16x32_bf16 v[36:39], v[32:35], v[124:127], v[36:39]
    s_nop 7
    v_mov_b32 v129, v36
    s_mov_b64 exec, 0xf
    s_cmp_eq_u32 s71, 0
    s_cbranch_scc1 S_17
    buffer_store_dwordx2 v[128:129], v7, s[40:43], s59 offen
S_18:
    s_mov_b64 exec, -1
L_nostat:
W_19:
    ds_read_b32 v2, v1 offset:0
    s_waitcnt lgkmcnt(0)
    v_readfirstlane_b32 s49, v2
    s_cmp_ge_i32 s49, 138
    s_cbranch_scc0 W_19
    ds_read_b64_tr_b16 v[164:165], v17 offset:16384
    ds_read_b64_tr_b16 v[166:167], v17 offset:18432
    ds_read_b64_tr_b16 v[168:169], v17 offset:20480
    ds_read_b64_tr_b16 v[170:171], v17 offset:22528
    ds_read_b64_tr_b16 v[172:173], v18 offset:16384
    ds_read_b64_tr_b16 v[174:175], v18 offset:18432
    ds_read_b64_tr_b16 v[176:177], v18 offset:20480
    ds_read_b64_tr_b16 v[178:179], v18 offset:22528
    ds_read2_b64 v[180:183], v28 offset0:160 offset1:164
    ds_read2_b64 v[184:187], v28 offset0:168 offset1:172
    ds_read_b32 v196, v31 offset:64
    s_waitcnt lgkmcnt(0)
    v_mfma_f32_16x16x32_bf16 v[188:191], v[164:167], v[180:183], 0
    v_mfma_f32_16x16x32_bf16 v[192:195], v[172:175], v[180:183], 0
    v_mfma_f32_16x16x32_bf16 v[188:191], v[168:171], v[184:187], v[188:191]
    v_mfma_f32_16x16x32_bf16 v[192:195], v[176:179], v[184:187], v[192:195]
    v_sub_f32 v32, 1.0, v196
    v_cvt_pk_bf16_f32 v32, v32, v32
    v_lshlrev_b32 v32, 16, v32
    v_and_b32 v33, 2, v0
    v_cmp_eq_u32 vcc, 0, v33
    s_nop 2
    v_cndmask_b32 v188, v188, v192, s[74:75]
    v_cndmask_b32 v189, v189, v193, s[74:75]
    v_cndmask_b32 v190, v190, v194, s[74:75]
    v_cndmask_b32 v191, v191, v195, s[74:75]
    v_mul_f32 v188, v188, v32
    v_mul_f32 v189, v189, v32
    v_mul_f32 v190, v190, v32
    v_mul_f32 v191, v191, v32
    v_cndmask_b32 v188, 0, v188, vcc
    v_cndmask_b32 v189, 0, v189, vcc
    v_cndmask_b32 v190, 0, v190, vcc
    v_cndmask_b32 v191, 0, v191, vcc
W_20:
    ds_read_b32 v2, v1 offset:0
    s_waitcnt lgkmcnt(0)
    v_readfirstlane_b32 s49, v2
    s_cmp_ge_i32 s49, 146
    s_cbranch_scc0 W_20
    ds_read_b64_tr_b16 v[32:33], v24 offset:0
    ds_read_b64_tr_b16 v[34:35], v24 offset:4096
    ds_read_b64_tr_b16 v[36:37], v25 offset:0
    ds_read_b64_tr_b16 v[38:39], v25 offset:4096
    ds_read_b64_tr_b16 v[40:41], v24 offset:8192
    ds_read_b64_tr_b16 v[42:43], v24 offset:12288
    ds_read_b64_tr_b16 v[44:45], v25 offset:8192
    ds_read_b64_tr_b16 v[46:47], v25 offset:12288
    ds_read_b64_tr_b16 v[48:49], v24 offset:16384
    ds_read_b64_tr_b16 v[50:51], v24 offset:20480
    ds_read_b64_tr_b16 v[52:53], v25 offset:16384
    ds_read_b64_tr_b16 v[54:55], v25 offset:20480
    s_waitcnt lgkmcnt(10)
    v_mfma_f32_16x16x32_bf16 v[200:203], v[32:35], v[96:99], 0
    s_waitcnt lgkmcnt(8)
    v_mfma_f32_16x16x32_bf16 v[204:207], v[36:39], v[96:99], 0
    s_waitcnt lgkmcnt(6)
    v_mfma_f32_16x16x32_bf16 v[200:203], v[40:43], v[100:103], v[200:203]
    s_waitcnt lgkmcnt(4)
    v_mfma_f32_16x16x32_bf16 v[204:207], v[44:47], v[100:103], v[204:207]
    s_waitcnt lgkmcnt(2)
    v_mfma_f32_16x16x32_bf16 v[200:203], v[48:51], v[104:107], v[200:203]
    s_waitcnt lgkmcnt(0)
    v_mfma_f32_16x16x32_bf16 v[204:207], v[52:55], v[104:107], v[204:207]
W_21:
    ds_read_b32 v2, v1 offset:0
    s_waitcnt lgkmcnt(0)
    v_readfirstlane_b32 s49, v2
    s_cmp_ge_i32 s49, 162
    s_cbranch_scc0 W_21
    ds_read_b64_tr_b16 v[32:33], v24 offset:24576
    ds_read_b64_tr_b16 v[34:35], v24 offset:28672
    ds_read_b64_tr_b16 v[36:37], v25 offset:24576
    ds_read_b64_tr_b16 v[38:39], v25 offset:28672
    ds_read_b64_tr_b16 v[40:41], v24 offset:32768
    ds_read_b64_tr_b16 v[42:43], v24 offset:36864
    ds_read_b64_tr_b16 v[44:45], v25 offset:32768
    ds_read_b64_tr_b16 v[46:47], v25 offset:36864
    s_waitcnt lgkmcnt(6)
    v_mfma_f32_16x16x32_bf16 v[200:203], v[32:35], v[108:111], v[200:203]
    s_waitcnt lgkmcnt(4)
    v_mfma_f32_16x16x32_bf16 v[204:207], v[36:39], v[108:111], v[204:207]
    s_waitcnt lgkmcnt(2)
    v_mfma_f32_16x16x32_bf16 v[200:203], v[40:43], v[112:115], v[200:203]
    s_waitcnt lgkmcnt(0)
    v_mfma_f32_16x16x32_bf16 v[204:207], v[44:47], v[112:115], v[204:207]
W_22:
    ds_read_b32 v2, v1 offset:0
    s_waitcnt lgkmcnt(0)
    v_readfirstlane_b32 s49, v2
    s_cmp_ge_i32 s49, 178
    s_cbranch_scc0 W_22
    ds_read_b64_tr_b16 v[32:33], v24 offset:40960
    ds_read_b64_tr_b16 v[34:35], v24 offset:45056
    ds_read_b64_tr_b16 v[36:37], v25 offset:40960
    ds_read_b64_tr_b16 v[38:39], v25 offset:45056
    ds_read_b64_tr_b16 v[40:41], v24 offset:49152
    ds_read_b64_tr_b16 v[42:43], v24 offset:53248
    ds_read_b64_tr_b16 v[44:45], v25 offset:49152
    ds_read_b64_tr_b16 v[46:47], v25 offset:53248
    s_waitcnt lgkmcnt(6)
    v_mfma_f32_16x16x32_bf16 v[200:203], v[32:35], v[116:119], v[200:203]
    s_waitcnt lgkmcnt(4)
    v_mfma_f32_16x16x32_bf16 v[204:207], v[36:39], v[116:119], v[204:207]
    s_waitcnt lgkmcnt(2)
    v_mfma_f32_16x16x32_bf16 v[200:203], v[40:43], v[120:123], v[200:203]
    s_waitcnt lgkmcnt(0)
    v_mfma_f32_16x16x32_bf16 v[204:207], v[44:47], v[120:123], v[204:207]
    s_barrier
    ds_read_b64_tr_b16 v[32:33], v24 offset:57344
    ds_read_b64_tr_b16 v[34:35], v24 offset:61440
    ds_read_b64_tr_b16 v[36:37], v25 offset:57344
    ds_read_b64_tr_b16 v[38:39], v25 offset:61440
    s_waitcnt lgkmcnt(2)
    v_mfma_f32_16x16x32_bf16 v[200:203], v[32:35], v[124:127], v[200:203]
    s_waitcnt lgkmcnt(0)
    v_mfma_f32_16x16x32_bf16 v[204:207], v[36:39], v[124:127], v[204:207]
    s_mov_b32 exec_lo, 0xf000f
    s_mov_b32 exec_hi, 0xf000f
    s_nop 4
    v_cvt_pk_bf16_f32 v32, v200, v201
    v_cvt_pk_bf16_f32 v33, v202, v203
    v_cvt_pk_bf16_f32 v34, v204, v205
    v_cvt_pk_bf16_f32 v35, v206, v207
    s_cmp_eq_u32 s71, 0
    s_cbranch_scc1 S_23
    buffer_store_dwordx4 v[32:35], v6, s[40:43], s58 offen
S_24:
    s_mov_b64 exec, -1
    buffer_load_dwordx2 v[56:57], v198, s[40:43], s69 offen sc1
    buffer_load_dwordx4 v[40:43], v197, s[40:43], s68 offen sc1
    buffer_load_dwordx4 v[44:47], v197, s[40:43], s68 offen offset:2048 sc1
    buffer_load_dwordx4 v[48:51], v197, s[40:43], s70 offen sc1
    buffer_load_dwordx4 v[52:55], v197, s[40:43], s70 offen offset:2048 sc1
    s_barrier
    ds_read_b64_tr_b16 v[132:133], v17 offset:0
    ds_read_b64_tr_b16 v[134:135], v17 offset:2048
    ds_read_b64_tr_b16 v[148:149], v18 offset:0
    ds_read_b64_tr_b16 v[150:151], v18 offset:2048
    ds_read_b64_tr_b16 v[136:137], v17 offset:4096
    ds_read_b64_tr_b16 v[138:139], v17 offset:6144
    ds_read_b64_tr_b16 v[152:153], v18 offset:4096
    ds_read_b64_tr_b16 v[154:155], v18 offset:6144
    ds_read_b64_tr_b16 v[140:141], v17 offset:8192
    ds_read_b64_tr_b16 v[142:143], v17 offset:10240
    ds_read_b64_tr_b16 v[156:157], v18 offset:8192
    ds_read_b64_tr_b16 v[158:159], v18 offset:10240
    s_waitcnt lgkmcnt(8)
    s_barrier
    ds_read_b64_tr_b16 v[144:145], v17 offset:12288
    ds_read_b64_tr_b16 v[146:147], v17 offset:14336
    ds_read_b64_tr_b16 v[160:161], v18 offset:12288
    ds_read_b64_tr_b16 v[162:163], v18 offset:14336
    s_branch L_gB1
L_gB:
    buffer_load_dwordx2 v[56:57], v198, s[40:43], s69 offen sc1
    buffer_load_dwordx4 v[40:43], v197, s[40:43], s68 offen sc1
    buffer_load_dwordx4 v[44:47], v197, s[40:43], s68 offen offset:2048 sc1
    buffer_load_dwordx4 v[48:51], v197, s[40:43], s70 offen sc1
    buffer_load_dwordx4 v[52:55], v197, s[40:43], s70 offen offset:2048 sc1
L_gB1:
    s_waitcnt vmcnt(0)
    v_max3_u32 v58, v40, v41, v42
    v_max3_u32 v59, v43, v44, v45
    v_max3_u32 v60, v46, v47, v48
    v_max3_u32 v58, v58, v49, v50
    v_max3_u32 v59, v59, v51, v52
    v_max3_u32 v60, v60, v53, v54
    v_max3_u32 v58, v58, v55, v56
    v_max3_u32 v59, v59, v60, v57
    v_max_u32 v58, v58, v59
    v_cmp_eq_u32 vcc, -1, v58
    s_cbranch_vccz L_gBdone
    s_mov_b64 exec, vcc
    s_sub_u32 s62, s62, 1
    s_cbranch_scc0 L_gB
    s_mov_b32 s62, 0
L_gBdone:
    s_mov_b64 exec, -1
    s_waitcnt lgkmcnt(0)
    v_mfma_f32_16x16x32_bf16 v[64:67], v[132:135], v[40:43], 0
    v_mfma_f32_16x16x32_bf16 v[68:71], v[148:151], v[40:43], 0
    v_mfma_f32_16x16x32_bf16 v[64:67], v[136:139], v[44:47], v[64:67]
    v_mfma_f32_16x16x32_bf16 v[68:71], v[152:155], v[44:47], v[68:71]
    v_mfma_f32_16x16x32_bf16 v[64:67], v[140:143], v[48:51], v[64:67]
    v_mfma_f32_16x16x32_bf16 v[68:71], v[156:159], v[48:51], v[68:71]
    v_mfma_f32_16x16x32_bf16 v[64:67], v[144:147], v[52:55], v[64:67]
    v_mfma_f32_16x16x32_bf16 v[68:71], v[160:163], v[52:55], v[68:71]
    v_max_f32_dpp v58, v56, v56 quad_perm:[1,0,3,2] row_mask:0xf bank_mask:0xf
    s_nop 1
    v_max_f32_dpp v58, v58, v58 quad_perm:[2,3,0,1] row_mask:0xf bank_mask:0xf
    v_sub_f32 v58, v56, v58
    v_exp_f32 v58, v58
    s_nop 0
    v_mul_f32 v59, v58, v57
    v_mul_f32 v58, v58, v196
    s_nop 0
    v_add_f32_dpp v59, v59, v59 quad_perm:[1,0,3,2] row_mask:0xf bank_mask:0xf
    s_nop 1
    v_add_f32_dpp v59, v59, v59 quad_perm:[2,3,0,1] row_mask:0xf bank_mask:0xf
    v_rcp_f32 v59, v59
    v_cndmask_b32 v72, v68, v64, s[74:75]
    v_cndmask_b32 v73, v69, v65, s[74:75]
    v_cndmask_b32 v74, v70, v66, s[74:75]
    v_cndmask_b32 v75, v71, v67, s[74:75]
    v_mul_f32 v58, v58, v59
    v_cndmask_b32 v64, v64, v68, s[74:75]
    v_cndmask_b32 v65, v65, v69, s[74:75]
    v_cndmask_b32 v66, v66, v70, s[74:75]
    v_cndmask_b32 v67, v67, v71, s[74:75]
    v_mov_b32_dpp v59, v58 quad_perm:[1,0,3,2] row_mask:0xf bank_mask:0xf
    v_fma_f32 v64, v64, v58, v188
    v_fma_f32 v65, v65, v58, v189
    v_fma_f32 v66, v66, v58, v190
    v_fma_f32 v67, v67, v58, v191
    v_fmac_f32_dpp v64, v72, v59 quad_perm:[1,0,3,2] row_mask:0xf bank_mask:0xf
    v_fmac_f32_dpp v65, v73, v59 quad_perm:[1,0,3,2] row_mask:0xf bank_mask:0xf
    v_fmac_f32_dpp v66, v74, v59 quad_perm:[1,0,3,2] row_mask:0xf bank_mask:0xf
    v_fmac_f32_dpp v67, v75, v59 quad_perm:[1,0,3,2] row_mask:0xf bank_mask:0xf
    v_add_f32_dpp v68, v64, v64 quad_perm:[2,3,0,1] row_mask:0xf bank_mask:0xf
    v_add_f32_dpp v69, v65, v65 quad_perm:[2,3,0,1] row_mask:0xf bank_mask:0xf
    v_add_f32_dpp v70, v66, v66 quad_perm:[2,3,0,1] row_mask:0xf bank_mask:0xf
    v_add_f32_dpp v71, v67, v67 quad_perm:[2,3,0,1] row_mask:0xf bank_mask:0xf
    s_mov_b32 exec_lo, 0x33333333
    s_mov_b32 exec_hi, 0x33333333
    v_bfi_b32 v68, s78, v199, v68
    v_bfi_b32 v69, s78, v199, v69
    v_bfi_b32 v70, s78, v199, v70
    v_bfi_b32 v71, s78, v199, v71
    buffer_store_dwordx4 v[68:71], v8, s[40:43], s60 offen sc1
    s_mov_b64 exec, -1
    s_cmp_eq_u32 s3, 0
    s_cbranch_scc0 L_end
    s_waitcnt vmcnt(0)
L_gC:
    buffer_load_dwordx4 v[32:35], v13, s[40:43], s72 offen sc1
    buffer_load_dwordx4 v[36:39], v13, s[40:43], s72 offen offset:1024 sc1
    s_waitcnt vmcnt(0)
    v_xor_b32 v32, s77, v32
    v_xor_b32 v33, s77, v33
    v_xor_b32 v34, s77, v34
    v_xor_b32 v35, s77, v35
    v_xor_b32 v36, s77, v36
    v_xor_b32 v37, s77, v37
    v_xor_b32 v38, s77, v38
    v_xor_b32 v39, s77, v39
    v_or3_b32 v40, v32, v33, v34
    v_or3_b32 v41, v35, v36, v37
    v_or3_b32 v40, v40, v38, v39
    v_bitop3_b32 v40, v40, v41, s78 bitop3:0xa8
    v_cmp_ne_u32 vcc, 0, v40
    s_cbranch_vccz L_gCdone
    s_mov_b64 exec, vcc
    s_sub_u32 s62, s62, 1
    s_cbranch_scc0 L_gC
    s_mov_b32 s62, 0
L_gCdone:
    s_mov_b64 exec, -1
    v_add_f32 v32, v32, v36
    v_add_f32 v33, v33, v37
    v_add_f32 v34, v34, v38
    v_add_f32 v35, v35, v39
    s_nop 0
    v_permlane32_swap_b32 v32, v34
    v_permlane32_swap_b32 v33, v35
    s_nop 0
    v_add_f32 v32, v32, v34
    v_add_f32 v33, v33, v35
    s_lshl2_add_u32 s63, s53, 811008
    v_mov_b32 v41, s76
    v_permlane16_swap_b32 v32, v33
    v_mov_b32 v42, 0
    v_add_f32 v32, v32, v33
    s_nop 1
    v_add_f32_dpp v32, v32, v32 row_ror:4 row_mask:0xf bank_mask:0xf
    s_nop 1
    v_add_f32_dpp v32, v32, v32 row_ror:8 row_mask:0xf bank_mask:0xf
    s_mov_b32 exec_lo, 0xf000f
    s_mov_b32 exec_hi, 0xf000f
    v_cvt_pk_bf16_f32 v32, v32, v32
    buffer_store_short v32, v14, s[36:39], s73 offen
    s_mov_b64 exec, 1
    buffer_store_dword v41, v42, s[40:43], s63 offen
    s_endpgm
L_chkslow:
    s_mov_b32 s50, 4
L_chksoft:
    buffer_load_dword v33, v101, s[40:43], s63 offen sc1
    s_waitcnt vmcnt(0)
    v_sub_u32 v34, v33, v32
    v_cmp_eq_u32 vcc, s61, v34
    v_add_u32 v34, -1, v34
    s_cmp_eq_u32 vcc_lo, -1
    s_cselect_b32 s71, 1, 0
    v_cmp_gt_u32 vcc, 8, v34
    s_cmp_eq_u32 vcc_lo, -1
    s_cbranch_scc1 L_chkback
    s_sub_u32 s50, s50, 1
    s_cbranch_scc0 L_chksoft
    s_lshl_b32 s49, s53, 7
    s_add_u32 s49, s49, 819200
    s_add_u32 s76, s77, s61
    v_mov_b32 v34, s76
    v_mov_b32 v35, 0
    s_mov_b64 exec, 1
    buffer_store_dword v34, v35, s[40:43], s49 offen sc1
    s_mov_b64 exec, -1
L_chkhard:
    buffer_load_dword v33, v101, s[40:43], s63 offen sc1
    s_waitcnt vmcnt(0)
    v_sub_u32 v34, v33, v32
    v_cmp_eq_u32 vcc, s61, v34
    v_add_u32 v34, -1, v34
    s_cmp_eq_u32 vcc_lo, -1
    s_cselect_b32 s71, 1, 0
    v_cmp_gt_u32 vcc, 8, v34
    s_cmp_eq_u32 vcc_lo, -1
    s_cbranch_scc1 L_chkback
    s_sleep 8
    s_sub_u32 s62, s62, 1
    s_cbranch_scc0 L_chkhard
    s_mov_b32 s62, 0
    s_branch L_chkback
L_impure:
    v_mov_b32 v36, v33
    s_mov_b32 exec_lo, 0xff00ff
    s_mov_b32 exec_hi, 0xff00ff
    buffer_store_dwordx4 v[96:99], v5, s[40:43], s57 offen sc1
    s_mov_b64 exec, -1
    s_cmp_eq_u32 s3, 0
    s_cbranch_scc0 L_imp1
    v_mov_b32 v32, -1
    v_mov_b32 v33, -1
    v_mov_b32 v34, -1
    v_mov_b32 v35, -1
    s_lshl_b32 s49, s53, 10
    s_add_u32 s49, s49, 524288
    buffer_store_dwordx4 v[32:35], v13, s[40:43], s49 offen sc1
    s_lshl_b32 s49, s53, 5
    s_add_u32 s49, s49, 786432
    s_mov_b64 exec, 3
    buffer_store_dwordx4 v[32:35], v13, s[40:43], s49 offen sc1
    s_mov_b64 exec, -1
L_imp1:
    s_waitcnt vmcnt(0)
    s_mov_b64 exec, 1
    ds_add_rtn_u32 v2, v1, v12 offset:4
    s_waitcnt lgkmcnt(0)
    v_readfirstlane_b32 s49, v2
    s_cmp_eq_u32 s49, 3
    s_cbranch_scc0 L_imp2
    s_lshl_b32 s49, s53, 7
    s_add_u32 s49, s49, 819200
    v_mov_b32 v32, s76
    v_mov_b32 v33, s76
    v_mov_b32 v34, 0
    buffer_store_dwordx2 v[32:33], v34, s[40:43], s49 offen sc1
L_imp2:
    s_mov_b64 exec, -1
L_imp3:
    buffer_load_dword v33, v101, s[40:43], s63 offen offset:4 sc1
    s_waitcnt vmcnt(0)
    v_cmp_eq_u32 vcc, v36, v33
    s_cmp_eq_u32 vcc_lo, -1
    s_cbranch_scc1 L_pure
    s_sleep 8
    s_sub_u32 s62, s62, 1
    s_cbranch_scc0 L_imp3
    s_mov_b32 s62, 0
    s_branch L_pure
S_17:
    buffer_store_dwordx2 v[128:129], v7, s[40:43], s59 offen sc1
    s_branch S_18
S_23:
    buffer_store_dwordx4 v[32:35], v6, s[40:43], s58 offen sc1
    s_branch S_24
L_end:
    s_endpgm
.section .rodata,"a"
.p2align 6
.amdhsa_kernel gated_mix__sliding_block_cached__glu_gated_swiglu__decode_kernel
  .amdhsa_next_free_vgpr 208
  .amdhsa_next_free_sgpr 102
  .amdhsa_accum_offset 208
  .amdhsa_group_segment_fixed_size 0
  .amdhsa_kernarg_size 104
  .amdhsa_user_sgpr_count 2
  .amdhsa_user_sgpr_kernarg_segment_ptr 1
  .amdhsa_system_sgpr_workgroup_id_x 1
  .amdhsa_float_denorm_mode_32 3
.end_amdhsa_kernel
```
